```python
import torch

def _softmax(x, axis=-1):
    return torch.softmax(x, dim=axis)
def _gelu(x):
    return torch.nn.functional.gelu(x, approximate="tanh")
def _silu(x):
    return torch.nn.functional.silu(x)
def _sigmoid(x):
    return torch.sigmoid(x)
def _layernorm(x, axis=-1, eps=1e-5):
    m = x.mean(dim=axis, keepdim=True)
    v = x.var(dim=axis, keepdim=True, unbiased=False)
    return (x - m) / torch.sqrt(v + eps)
def _scatter_add(tgt, idx, src, axis=0):
    return tgt.clone().index_add_(axis, idx, src)
def _segment_sum(src, seg, n):
    out = torch.zeros((n,) + src.shape[1:], dtype=src.dtype)
    return out.index_add_(0, seg, src)
def _pad(x, pw):
    flat = tuple(v for pair in reversed(pw) for v in pair)
    return torch.nn.functional.pad(x, flat)

kernel_name = 'standalone__softmax_full_bidir__sampling'

def setup_inputs():

    _w = (lambda a: (lambda t: t.to(torch.bfloat16) if t.is_floating_point() else t)(torch.as_tensor(a)))
    B, H, Sq, Skv, Dh = 8, 32, 1, 4096, 128
    return {
        "q": _w((lambda *s: torch.randn(*s, dtype=torch.bfloat16) * 0.8)(B, H, Sq, Dh)),
        "k": _w((lambda *s: torch.randn(*s, dtype=torch.bfloat16) * 0.8)(B, H, Skv, Dh)),
        "v": _w((lambda *s: torch.randn(*s, dtype=torch.bfloat16) * 0.05)(B, H, Skv, Dh)),
    }

def reference(q, k, v):
    scale = q.shape[-1] ** -0.5
    scores = torch.einsum('bhqd,bhkd->bhqk', q, k) * scale
    attn = _softmax(scores, axis=-1)
    return torch.einsum('bhqk,bhkd->bhqd', attn, v)
```

```asm
; @launch grid=(256,1,1) block=(256,1,1) lds=18464
.amdgcn_target "amdgcn-amd-amdhsa--gfx950"
.text
.globl standalone__softmax_full_bidir__sampling_kernel
.p2align 8
.type standalone__softmax_full_bidir__sampling_kernel,@function
standalone__softmax_full_bidir__sampling_kernel:
  s_load_dwordx8 s[44:51], s[0:1], 0
  s_load_dwordx2 s[36:37], s[0:1], 32
  s_cmp_ge_u32 s2, 256
  s_cbranch_scc1 L_end
  v_and_b32 v3, 63, v0
  v_and_b32 v1, 31, v0
  v_lshlrev_b32 v1, 4, v1
  v_bfe_u32 v2, v0, 5, 1
  v_lshl_add_u32 v1, v2, 13, v1
  v_bfe_u32 v2, v0, 6, 1
  v_lshl_add_u32 v1, v2, 9, v1
  v_lshrrev_b32 v2, 7, v0
  v_lshl_add_u32 v1, v2, 16, v1
  s_lshl_b32 s5, s2, 20
  s_mov_b32 s26, 0x100000
  s_mov_b32 s27, 0x20000
  s_mov_b32 s28, 0
  s_or_b32 s29, s28, 0x1000
  s_lshl_b32 s6, s2, 8
  v_and_b32 v2, 15, v0
  v_lshlrev_b32 v2, 4, v2
  s_mov_b32 s18, 256
  s_mov_b32 s19, 0x20000
  s_waitcnt lgkmcnt(0)
  s_add_u32 s24, s46, s5
  s_addc_u32 s25, s47, 0
  buffer_load_dwordx4 v[32:35], v1, s[24:27], s28 offen offset:0 nt
  s_add_u32 s16, s44, s6
  s_addc_u32 s17, s45, 0
  buffer_load_dwordx4 v[4:7], v2, s[16:19], 0 offen nt
  buffer_load_dwordx4 v[36:39], v1, s[24:27], s28 offen offset:1024 nt
  buffer_load_dwordx4 v[40:43], v1, s[24:27], s28 offen offset:2048 nt
  buffer_load_dwordx4 v[44:47], v1, s[24:27], s28 offen offset:3072 nt
  buffer_load_dwordx4 v[48:51], v1, s[24:27], s29 offen offset:0 nt
  buffer_load_dwordx4 v[52:55], v1, s[24:27], s29 offen offset:1024 nt
  buffer_load_dwordx4 v[56:59], v1, s[24:27], s29 offen offset:2048 nt
  v_lshrrev_b32 v2, 6, v0
  s_add_u32 s12, s48, s5
  s_addc_u32 s13, s49, 0
  v_readfirstlane_b32 s43, v2
  s_add_u32 s20, s50, s6
  s_addc_u32 s21, s51, 0
  s_mov_b32 s22, 256
  s_mov_b32 s23, 0x20000
  s_mov_b32 s30, 0
  s_load_dword s73, s[36:37], 0
  s_mov_b32 s40, 0x3e0293ee
  s_mov_b32 s41, 0xffff0000
  s_mov_b32 s32, 0xcccccccc
  s_mov_b32 s33, 0xcccccccc
  s_mov_b32 s34, 0xaaaaaaaa
  s_mov_b32 s35, 0xaaaaaaaa
  s_mul_i32 s3, s43, 4096
  v_lshl_add_u32 v14, v3, 2, s3
  v_mov_b32 v8, 0xff7fffff
  v_mov_b32 v9, 0
  v_mov_b32 v16, 0
  v_mov_b32 v17, 0
  v_mov_b32 v18, 0
  v_mov_b32 v19, 0
  v_mov_b32 v20, 0
  v_mov_b32 v21, 0
  v_mov_b32 v22, 0
  v_mov_b32 v23, 0
  s_mov_b32 s38, 32
  s_mov_b32 s39, 0x20000
  s_mov_b32 s52, 1
  s_mov_b32 s53, 0
  s_mov_b32 s54, 0
  s_mov_b32 s55, 0
  s_mov_b32 s70, 0
  s_mov_b32 s79, 0
  s_and_b32 s69, s43, 3
  s_add_u32 s69, s69, 1
  v_and_b32 v65, 7, v3
  v_lshlrev_b32 v65, 2, v65
  s_lshl_b32 s3, s2, 2
  v_lshl_add_u32 v66, v3, 5, s3
  s_lshr_b32 s3, s2, 3
  s_or_b32 s3, s3, s43
  s_cmp_eq_u32 s3, 0
  s_cselect_b32 s71, 0x10408082, 0
  s_and_b32 s3, s43, 3
  s_lshl_b32 s72, 0x20810104, s3
  s_mov_b32 s42, 16
L_kloop:
  s_cmp_eq_u32 s52, 0
  s_cselect_b64 vcc, -1, 0
  s_cmp_eq_u32 s52, 2
  s_cbranch_vccnz L_1
  s_cbranch_scc0 L_2
  s_waitcnt vmcnt(3)
L_2:
  s_waitcnt vmcnt(4)
L_1:
  s_waitcnt vmcnt(5)
  buffer_load_dwordx4 v[60:63], v1, s[24:27], s29 offen offset:3072 nt
  s_or_b32 s28, s28, 0x13fff
  s_add_u32 s28, s28, 1
  s_and_b32 s28, s28, 0xec000
  s_or_b32 s29, s28, 0x1000
  s_add_u32 s30, s30, 1
  s_cmp_eq_u32 s30, 32
  s_cselect_b64 s[24:25], s[12:13], s[24:25]
  s_cmp_ge_u32 s30, 64
  s_cselect_b32 s26, 0, s26
  v_dot2_f32_bf16 v24, v32, v4, 0
  v_dot2_f32_bf16 v24, v33, v5, v24
  v_dot2_f32_bf16 v24, v34, v6, v24
  v_dot2_f32_bf16 v24, v35, v7, v24
  s_cmp_eq_u32 s52, 0
  s_cselect_b64 vcc, -1, 0
  s_cmp_eq_u32 s52, 2
  s_cbranch_vccnz L_3
  s_cbranch_scc0 L_4
  s_waitcnt vmcnt(3)
L_4:
  s_waitcnt vmcnt(4)
L_3:
  s_waitcnt vmcnt(5)
  buffer_load_dwordx4 v[32:35], v1, s[24:27], s28 offen offset:0 nt
  v_dot2_f32_bf16 v25, v36, v4, 0
  v_dot2_f32_bf16 v25, v37, v5, v25
  v_dot2_f32_bf16 v25, v38, v6, v25
  v_dot2_f32_bf16 v25, v39, v7, v25
  s_lshr_b32 s3, s30, 1
  s_bitcmp1_b32 s72, s3
  s_cbranch_scc0 L_5
  buffer_load_dword v64, v65, s[36:39], 0 offen sc1
L_5:
  s_cmp_eq_u32 s52, 0
  s_cselect_b64 vcc, -1, 0
  s_cmp_eq_u32 s52, 2
  s_cbranch_vccnz L_6
  s_cbranch_scc0 L_7
  s_waitcnt vmcnt(3)
L_7:
  s_waitcnt vmcnt(4)
L_6:
  s_waitcnt vmcnt(5)
  buffer_load_dwordx4 v[36:39], v1, s[24:27], s28 offen offset:1024 nt
  s_memrealtime s[74:75]
  s_nop 0
  v_add_f32_dpp v26, v24, v24 row_ror:8 row_mask:0xf bank_mask:0xf
  v_add_f32_dpp v26, v25, v25 row_ror:8 row_mask:0xf bank_mask:0xc
  v_dot2_f32_bf16 v24, v40, v4, 0
  v_dot2_f32_bf16 v24, v41, v5, v24
  v_dot2_f32_bf16 v24, v42, v6, v24
  v_dot2_f32_bf16 v24, v43, v7, v24
  s_cbranch_vccnz L_8
  s_cbranch_scc0 L_9
  s_waitcnt vmcnt(3)
L_9:
  s_waitcnt vmcnt(4)
L_8:
  s_waitcnt vmcnt(5)
  buffer_load_dwordx4 v[40:43], v1, s[24:27], s28 offen offset:2048 nt
  v_dot2_f32_bf16 v25, v44, v4, 0
  v_dot2_f32_bf16 v25, v45, v5, v25
  v_dot2_f32_bf16 v25, v46, v6, v25
  v_dot2_f32_bf16 v25, v47, v7, v25
  s_cbranch_vccnz L_10
  s_cbranch_scc0 L_11
  s_waitcnt vmcnt(3)
L_11:
  s_waitcnt vmcnt(4)
L_10:
  s_waitcnt vmcnt(5)
  buffer_load_dwordx4 v[44:47], v1, s[24:27], s28 offen offset:3072 nt
  s_nop 0
  v_add_f32_dpp v27, v24, v24 row_ror:8 row_mask:0xf bank_mask:0xf
  v_add_f32_dpp v27, v25, v25 row_ror:8 row_mask:0xf bank_mask:0xc
  s_nop 1
  v_add_f32_dpp v28, v26, v26 row_half_mirror row_mask:0xf bank_mask:0xf
  v_add_f32_dpp v28, v27, v27 row_half_mirror row_mask:0xf bank_mask:0xa
  v_dot2_f32_bf16 v24, v48, v4, 0
  v_dot2_f32_bf16 v24, v49, v5, v24
  v_dot2_f32_bf16 v24, v50, v6, v24
  v_dot2_f32_bf16 v24, v51, v7, v24
  s_cbranch_vccnz L_12
  s_cbranch_scc0 L_13
  s_waitcnt vmcnt(3)
L_13:
  s_waitcnt vmcnt(4)
L_12:
  s_waitcnt vmcnt(5)
  buffer_load_dwordx4 v[48:51], v1, s[24:27], s29 offen offset:0 nt
  v_dot2_f32_bf16 v25, v52, v4, 0
  v_dot2_f32_bf16 v25, v53, v5, v25
  v_dot2_f32_bf16 v25, v54, v6, v25
  v_dot2_f32_bf16 v25, v55, v7, v25
  s_cbranch_vccnz L_14
  s_cbranch_scc0 L_15
  s_waitcnt vmcnt(3)
L_15:
  s_waitcnt vmcnt(4)
L_14:
  s_waitcnt vmcnt(5)
  buffer_load_dwordx4 v[52:55], v1, s[24:27], s29 offen offset:1024 nt
  s_nop 0
  v_add_f32_dpp v26, v24, v24 row_ror:8 row_mask:0xf bank_mask:0xf
  v_add_f32_dpp v26, v25, v25 row_ror:8 row_mask:0xf bank_mask:0xc
  v_dot2_f32_bf16 v24, v56, v4, 0
  v_dot2_f32_bf16 v24, v57, v5, v24
  v_dot2_f32_bf16 v24, v58, v6, v24
  v_dot2_f32_bf16 v24, v59, v7, v24
  s_cbranch_vccnz L_16
  s_cbranch_scc0 L_17
  s_waitcnt vmcnt(3)
L_17:
  s_waitcnt vmcnt(4)
L_16:
  s_waitcnt vmcnt(5)
  buffer_load_dwordx4 v[56:59], v1, s[24:27], s29 offen offset:2048 nt
  v_dot2_f32_bf16 v25, v60, v4, 0
  v_dot2_f32_bf16 v25, v61, v5, v25
  v_dot2_f32_bf16 v25, v62, v6, v25
  v_dot2_f32_bf16 v25, v63, v7, v25
  s_add_u32 s53, s53, 107
  s_waitcnt lgkmcnt(0)
  s_sub_u32 s70, s53, s74
  s_sub_u32 s3, s70, s54
  s_cmp_gt_i32 s3, -30
  s_cselect_b32 s52, 1, 0
  s_cmp_gt_i32 s3, 30
  s_cselect_b32 s52, 2, s52
  s_cmp_eq_u32 s55, 0
  s_cselect_b32 s52, 1, s52
  s_cmp_ge_u32 s30, 62
  s_cselect_b32 s52, 0, s52
  s_cmp_eq_u32 s52, 0
  s_cselect_b64 vcc, -1, 0
  s_cmp_eq_u32 s52, 2
  s_cbranch_vccnz L_18
  s_cbranch_scc0 L_19
  s_waitcnt vmcnt(3)
L_19:
  s_waitcnt vmcnt(4)
L_18:
  s_waitcnt vmcnt(5)
  buffer_load_dwordx4 v[60:63], v1, s[24:27], s29 offen offset:3072 nt
  s_or_b32 s28, s28, 0x13fff
  s_add_u32 s28, s28, 1
  s_and_b32 s28, s28, 0xec000
  s_or_b32 s29, s28, 0x1000
  s_add_u32 s30, s30, 1
  s_cmp_eq_u32 s30, 32
  s_cselect_b64 s[24:25], s[12:13], s[24:25]
  s_cmp_ge_u32 s30, 64
  s_cselect_b32 s26, 0, s26
  s_nop 0
  v_add_f32_dpp v27, v24, v24 row_ror:8 row_mask:0xf bank_mask:0xf
  v_add_f32_dpp v27, v25, v25 row_ror:8 row_mask:0xf bank_mask:0xc
  s_nop 1
  v_add_f32_dpp v29, v26, v26 row_half_mirror row_mask:0xf bank_mask:0xf
  v_add_f32_dpp v29, v27, v27 row_half_mirror row_mask:0xf bank_mask:0xa
  s_nop 1
  v_add_f32_dpp v28, v28, v28 quad_perm:[2,3,0,1] row_mask:0xf bank_mask:0xf
  v_add_f32_dpp v29, v29, v29 quad_perm:[2,3,0,1] row_mask:0xf bank_mask:0xf
  v_cndmask_b32 v30, v28, v29, s[32:33]
  v_dot2_f32_bf16 v24, v32, v4, 0
  v_dot2_f32_bf16 v24, v33, v5, v24
  v_dot2_f32_bf16 v24, v34, v6, v24
  v_dot2_f32_bf16 v24, v35, v7, v24
  s_cmp_eq_u32 s52, 0
  s_cselect_b64 vcc, -1, 0
  s_cmp_eq_u32 s52, 2
  s_cbranch_vccnz L_20
  s_cbranch_scc0 L_21
  s_waitcnt vmcnt(3)
L_21:
  s_waitcnt vmcnt(4)
L_20:
  s_waitcnt vmcnt(5)
  buffer_load_dwordx4 v[32:35], v1, s[24:27], s28 offen offset:0 nt
  v_dot2_f32_bf16 v25, v36, v4, 0
  v_dot2_f32_bf16 v25, v37, v5, v25
  v_dot2_f32_bf16 v25, v38, v6, v25
  v_dot2_f32_bf16 v25, v39, v7, v25
  s_cbranch_vccnz L_22
  s_cbranch_scc0 L_23
  s_waitcnt vmcnt(3)
L_23:
  s_waitcnt vmcnt(4)
L_22:
  s_waitcnt vmcnt(5)
  buffer_load_dwordx4 v[36:39], v1, s[24:27], s28 offen offset:1024 nt
  s_memrealtime s[74:75]
  s_nop 0
  v_add_f32_dpp v26, v24, v24 row_ror:8 row_mask:0xf bank_mask:0xf
  v_add_f32_dpp v26, v25, v25 row_ror:8 row_mask:0xf bank_mask:0xc
  v_dot2_f32_bf16 v24, v40, v4, 0
  v_dot2_f32_bf16 v24, v41, v5, v24
  v_dot2_f32_bf16 v24, v42, v6, v24
  v_dot2_f32_bf16 v24, v43, v7, v24
  s_cbranch_vccnz L_24
  s_cbranch_scc0 L_25
  s_waitcnt vmcnt(3)
L_25:
  s_waitcnt vmcnt(4)
L_24:
  s_waitcnt vmcnt(5)
  buffer_load_dwordx4 v[40:43], v1, s[24:27], s28 offen offset:2048 nt
  v_dot2_f32_bf16 v25, v44, v4, 0
  v_dot2_f32_bf16 v25, v45, v5, v25
  v_dot2_f32_bf16 v25, v46, v6, v25
  v_dot2_f32_bf16 v25, v47, v7, v25
  s_cbranch_vccnz L_26
  s_cbranch_scc0 L_27
  s_waitcnt vmcnt(3)
L_27:
  s_waitcnt vmcnt(4)
L_26:
  s_waitcnt vmcnt(5)
  buffer_load_dwordx4 v[44:47], v1, s[24:27], s28 offen offset:3072 nt
  s_nop 0
  v_add_f32_dpp v27, v24, v24 row_ror:8 row_mask:0xf bank_mask:0xf
  v_add_f32_dpp v27, v25, v25 row_ror:8 row_mask:0xf bank_mask:0xc
  s_nop 1
  v_add_f32_dpp v28, v26, v26 row_half_mirror row_mask:0xf bank_mask:0xf
  v_add_f32_dpp v28, v27, v27 row_half_mirror row_mask:0xf bank_mask:0xa
  v_dot2_f32_bf16 v24, v48, v4, 0
  v_dot2_f32_bf16 v24, v49, v5, v24
  v_dot2_f32_bf16 v24, v50, v6, v24
  v_dot2_f32_bf16 v24, v51, v7, v24
  s_lshr_b32 s3, s30, 1
  s_sub_u32 s3, s3, 1
  s_bitcmp1_b32 s72, s3
  s_cbranch_scc0 L_28
  v_subrev_u32 v68, s70, v64
  v_add_u32 v64, 2000, v68
  v_cmp_gt_u32 vcc, 4000, v64
  s_nop 1
  v_cndmask_b32 v68, 0, v68, vcc
  v_mov_b32 v69, v68
  s_nop 1
  v_add_u32_dpp v68, v68, v68 quad_perm:[1,0,3,2] row_mask:0xf bank_mask:0xf
  v_min_i32_dpp v69, v69, v69 quad_perm:[1,0,3,2] row_mask:0xf bank_mask:0xf
  s_nop 0
  v_add_u32_dpp v68, v68, v68 quad_perm:[2,3,0,1] row_mask:0xf bank_mask:0xf
  v_min_i32_dpp v69, v69, v69 quad_perm:[2,3,0,1] row_mask:0xf bank_mask:0xf
  s_nop 0
  v_add_u32_dpp v68, v68, v68 row_half_mirror row_mask:0xf bank_mask:0xf
  v_min_i32_dpp v69, v69, v69 row_half_mirror row_mask:0xf bank_mask:0xf
  s_nop 0
  v_readfirstlane_b32 s3, v68
  v_readfirstlane_b32 s4, v69
  s_cmp_eq_u32 s55, 0
  s_cselect_b32 s5, 2, 5
  s_sub_u32 s6, 8, s5
  s_mul_i32 s3, s3, s6
  s_lshl_b32 s4, s4, 3
  s_mul_i32 s4, s4, s5
  s_add_i32 s3, s3, s4
  s_ashr_i32 s3, s3, 6
  s_add_u32 s3, s70, s3
  s_mul_i32 s4, s79, s69
  s_add_u32 s3, s3, s4
  s_sub_u32 s4, s3, s54
  s_mov_b32 s54, s3
  s_cmp_gt_i32 s4, -20
  s_cselect_b32 s3, 1, 0
  s_add_i32 s3, s3, s79
  s_cmp_lt_i32 s4, -35
  s_cselect_b32 s4, 1, 0
  s_sub_i32 s3, s3, s4
  s_min_i32 s3, s3, 4
  s_cmp_eq_u32 s55, 0
  s_cselect_b32 s79, 0, s3
  s_mov_b32 s55, 1
L_28:
  s_cmp_eq_u32 s52, 0
  s_cselect_b64 vcc, -1, 0
  s_cmp_eq_u32 s52, 2
  s_cbranch_vccnz L_29
  s_cbranch_scc0 L_30
  s_waitcnt vmcnt(3)
L_30:
  s_waitcnt vmcnt(4)
L_29:
  s_waitcnt vmcnt(5)
  buffer_load_dwordx4 v[48:51], v1, s[24:27], s29 offen offset:0 nt
  v_dot2_f32_bf16 v25, v52, v4, 0
  v_dot2_f32_bf16 v25, v53, v5, v25
  v_dot2_f32_bf16 v25, v54, v6, v25
  v_dot2_f32_bf16 v25, v55, v7, v25
  s_cbranch_vccnz L_31
  s_cbranch_scc0 L_32
  s_waitcnt vmcnt(3)
L_32:
  s_waitcnt vmcnt(4)
L_31:
  s_waitcnt vmcnt(5)
  buffer_load_dwordx4 v[52:55], v1, s[24:27], s29 offen offset:1024 nt
  s_nop 0
  v_add_f32_dpp v26, v24, v24 row_ror:8 row_mask:0xf bank_mask:0xf
  v_add_f32_dpp v26, v25, v25 row_ror:8 row_mask:0xf bank_mask:0xc
  v_dot2_f32_bf16 v24, v56, v4, 0
  v_dot2_f32_bf16 v24, v57, v5, v24
  v_dot2_f32_bf16 v24, v58, v6, v24
  v_dot2_f32_bf16 v24, v59, v7, v24
  s_cbranch_vccnz L_33
  s_cbranch_scc0 L_34
  s_waitcnt vmcnt(3)
L_34:
  s_waitcnt vmcnt(4)
L_33:
  s_waitcnt vmcnt(5)
  buffer_load_dwordx4 v[56:59], v1, s[24:27], s29 offen offset:2048 nt
  v_dot2_f32_bf16 v25, v60, v4, 0
  v_dot2_f32_bf16 v25, v61, v5, v25
  v_dot2_f32_bf16 v25, v62, v6, v25
  v_dot2_f32_bf16 v25, v63, v7, v25
  s_nop 2
  v_add_f32_dpp v27, v24, v24 row_ror:8 row_mask:0xf bank_mask:0xf
  v_add_f32_dpp v27, v25, v25 row_ror:8 row_mask:0xf bank_mask:0xc
  s_nop 1
  v_add_f32_dpp v29, v26, v26 row_half_mirror row_mask:0xf bank_mask:0xf
  v_add_f32_dpp v29, v27, v27 row_half_mirror row_mask:0xf bank_mask:0xa
  s_nop 1
  v_add_f32_dpp v28, v28, v28 quad_perm:[2,3,0,1] row_mask:0xf bank_mask:0xf
  v_add_f32_dpp v29, v29, v29 quad_perm:[2,3,0,1] row_mask:0xf bank_mask:0xf
  v_cndmask_b32 v31, v28, v29, s[32:33]
  s_nop 1
  v_add_f32_dpp v30, v30, v30 quad_perm:[1,0,3,2] row_mask:0xf bank_mask:0xf
  v_add_f32_dpp v31, v31, v31 quad_perm:[1,0,3,2] row_mask:0xf bank_mask:0xf
  v_cndmask_b32 v15, v30, v31, s[34:35]
  v_mul_f32 v15, s40, v15
  ds_write_b32 v14, v15
  v_max_f32 v8, v8, v15
  v_add_u32 v14, 256, v14
  s_add_u32 s53, s53, 107
  s_waitcnt lgkmcnt(0)
  s_sub_u32 s70, s53, s74
  s_add_u32 s54, s54, s79
  s_sub_u32 s3, s70, s54
  s_cmp_gt_i32 s3, -30
  s_cselect_b32 s52, 1, 0
  s_cmp_gt_i32 s3, 30
  s_cselect_b32 s52, 2, s52
  s_cmp_eq_u32 s55, 0
  s_cselect_b32 s52, 1, s52
  s_cmp_ge_u32 s30, 62
  s_cselect_b32 s52, 0, s52
  s_lshr_b32 s3, s30, 1
  s_bitcmp1_b32 s71, s3
  s_cbranch_scc0 L_35
  v_mov_b32 v68, s70
  buffer_store_dword v68, v66, s[36:39], 0 offen sc1
L_35:
  s_sub_u32 s42, s42, 1
  s_cmp_lg_u32 s42, 0
  s_cbranch_scc1 L_kloop
  v_subrev_u32 v14, 4096, v14
  ds_read_b32 v11, v14
  s_nop 1
  v_max_f32_dpp v8, v8, v8 row_ror:8 row_mask:0xf bank_mask:0xf
  s_nop 1
  v_max_f32_dpp v8, v8, v8 row_ror:4 row_mask:0xf bank_mask:0xf
  s_nop 1
  v_max_f32_dpp v8, v8, v8 row_ror:2 row_mask:0xf bank_mask:0xf
  s_nop 1
  v_max_f32_dpp v8, v8, v8 row_ror:1 row_mask:0xf bank_mask:0xf
  v_mov_b32 v15, v8
  s_nop 1
  v_permlane16_swap_b32 v8, v15
  s_nop 1
  v_max_f32 v8, v8, v15
  v_mov_b32 v15, v8
  s_nop 1
  v_permlane32_swap_b32 v8, v15
  s_nop 1
  v_max_f32 v8, v8, v15
  s_mov_b32 s42, 16
L_vloop:
  s_cmp_eq_u32 s52, 0
  s_cselect_b64 vcc, -1, 0
  s_cmp_eq_u32 s52, 2
  s_cbranch_vccnz L_36
  s_cbranch_scc0 L_37
  s_waitcnt vmcnt(3)
L_37:
  s_waitcnt vmcnt(4)
L_36:
  s_waitcnt vmcnt(5)
  buffer_load_dwordx4 v[60:63], v1, s[24:27], s29 offen offset:3072 nt
  s_or_b32 s28, s28, 0x13fff
  s_add_u32 s28, s28, 1
  s_and_b32 s28, s28, 0xec000
  s_or_b32 s29, s28, 0x1000
  s_add_u32 s30, s30, 1
  s_cmp_eq_u32 s30, 32
  s_cselect_b64 s[24:25], s[12:13], s[24:25]
  s_cmp_ge_u32 s30, 64
  s_cselect_b32 s26, 0, s26
  s_waitcnt lgkmcnt(0)
  v_sub_f32 v10, v11, v8
  v_add_u32 v14, 256, v14
  v_exp_f32 v10, v10
  ds_read_b32 v11, v14
  s_nop 0
  v_add_f32 v9, v9, v10
  v_mov_b32_dpp v12, v10 row_newbcast:0 row_mask:0xf bank_mask:0xf
  v_lshlrev_b32 v24, 16, v32
  v_and_b32 v25, s41, v32
  v_lshlrev_b32 v26, 16, v33
  v_and_b32 v27, s41, v33
  v_lshlrev_b32 v28, 16, v34
  v_and_b32 v29, s41, v34
  v_lshlrev_b32 v30, 16, v35
  v_and_b32 v31, s41, v35
  v_pk_fma_f32 v[16:17], v[24:25], v[12:13], v[16:17] op_sel:[0,0,0] op_sel_hi:[1,0,1]
  v_pk_fma_f32 v[18:19], v[26:27], v[12:13], v[18:19] op_sel:[0,0,0] op_sel_hi:[1,0,1]
  v_pk_fma_f32 v[20:21], v[28:29], v[12:13], v[20:21] op_sel:[0,0,0] op_sel_hi:[1,0,1]
  v_pk_fma_f32 v[22:23], v[30:31], v[12:13], v[22:23] op_sel:[0,0,0] op_sel_hi:[1,0,1]
  s_cmp_eq_u32 s52, 0
  s_cselect_b64 vcc, -1, 0
  s_cmp_eq_u32 s52, 2
  s_cbranch_vccnz L_38
  s_cbranch_scc0 L_39
  s_waitcnt vmcnt(3)
L_39:
  s_waitcnt vmcnt(4)
L_38:
  s_waitcnt vmcnt(5)
  buffer_load_dwordx4 v[32:35], v1, s[24:27], s28 offen offset:0 nt
  v_mov_b32_dpp v13, v10 row_newbcast:8 row_mask:0xf bank_mask:0xf
  v_lshlrev_b32 v24, 16, v36
  v_and_b32 v25, s41, v36
  v_lshlrev_b32 v26, 16, v37
  v_and_b32 v27, s41, v37
  v_lshlrev_b32 v28, 16, v38
  v_and_b32 v29, s41, v38
  v_lshlrev_b32 v30, 16, v39
  v_and_b32 v31, s41, v39
  v_pk_fma_f32 v[16:17], v[24:25], v[12:13], v[16:17] op_sel:[0,1,0] op_sel_hi:[1,1,1]
  v_pk_fma_f32 v[18:19], v[26:27], v[12:13], v[18:19] op_sel:[0,1,0] op_sel_hi:[1,1,1]
  v_pk_fma_f32 v[20:21], v[28:29], v[12:13], v[20:21] op_sel:[0,1,0] op_sel_hi:[1,1,1]
  v_pk_fma_f32 v[22:23], v[30:31], v[12:13], v[22:23] op_sel:[0,1,0] op_sel_hi:[1,1,1]
  s_lshr_b32 s3, s30, 1
  s_bitcmp1_b32 s72, s3
  s_cbranch_scc0 L_40
  buffer_load_dword v64, v65, s[36:39], 0 offen sc1
L_40:
  s_cmp_eq_u32 s52, 0
  s_cselect_b64 vcc, -1, 0
  s_cmp_eq_u32 s52, 2
  s_cbranch_vccnz L_41
  s_cbranch_scc0 L_42
  s_waitcnt vmcnt(3)
L_42:
  s_waitcnt vmcnt(4)
L_41:
  s_waitcnt vmcnt(5)
  buffer_load_dwordx4 v[36:39], v1, s[24:27], s28 offen offset:1024 nt
  s_memrealtime s[74:75]
  v_mov_b32_dpp v12, v10 row_newbcast:4 row_mask:0xf bank_mask:0xf
  v_lshlrev_b32 v24, 16, v40
  v_and_b32 v25, s41, v40
  v_lshlrev_b32 v26, 16, v41
  v_and_b32 v27, s41, v41
  v_lshlrev_b32 v28, 16, v42
  v_and_b32 v29, s41, v42
  v_lshlrev_b32 v30, 16, v43
  v_and_b32 v31, s41, v43
  v_pk_fma_f32 v[16:17], v[24:25], v[12:13], v[16:17] op_sel:[0,0,0] op_sel_hi:[1,0,1]
  v_pk_fma_f32 v[18:19], v[26:27], v[12:13], v[18:19] op_sel:[0,0,0] op_sel_hi:[1,0,1]
  v_pk_fma_f32 v[20:21], v[28:29], v[12:13], v[20:21] op_sel:[0,0,0] op_sel_hi:[1,0,1]
  v_pk_fma_f32 v[22:23], v[30:31], v[12:13], v[22:23] op_sel:[0,0,0] op_sel_hi:[1,0,1]
  s_cbranch_vccnz L_43
  s_cbranch_scc0 L_44
  s_waitcnt vmcnt(3)
L_44:
  s_waitcnt vmcnt(4)
L_43:
  s_waitcnt vmcnt(5)
  buffer_load_dwordx4 v[40:43], v1, s[24:27], s28 offen offset:2048 nt
  v_mov_b32_dpp v13, v10 row_newbcast:12 row_mask:0xf bank_mask:0xf
  v_lshlrev_b32 v24, 16, v44
  v_and_b32 v25, s41, v44
  v_lshlrev_b32 v26, 16, v45
  v_and_b32 v27, s41, v45
  v_lshlrev_b32 v28, 16, v46
  v_and_b32 v29, s41, v46
  v_lshlrev_b32 v30, 16, v47
  v_and_b32 v31, s41, v47
  v_pk_fma_f32 v[16:17], v[24:25], v[12:13], v[16:17] op_sel:[0,1,0] op_sel_hi:[1,1,1]
  v_pk_fma_f32 v[18:19], v[26:27], v[12:13], v[18:19] op_sel:[0,1,0] op_sel_hi:[1,1,1]
  v_pk_fma_f32 v[20:21], v[28:29], v[12:13], v[20:21] op_sel:[0,1,0] op_sel_hi:[1,1,1]
  v_pk_fma_f32 v[22:23], v[30:31], v[12:13], v[22:23] op_sel:[0,1,0] op_sel_hi:[1,1,1]
  s_cbranch_vccnz L_45
  s_cbranch_scc0 L_46
  s_waitcnt vmcnt(3)
L_46:
  s_waitcnt vmcnt(4)
L_45:
  s_waitcnt vmcnt(5)
  buffer_load_dwordx4 v[44:47], v1, s[24:27], s28 offen offset:3072 nt
  v_mov_b32_dpp v12, v10 row_newbcast:2 row_mask:0xf bank_mask:0xf
  v_lshlrev_b32 v24, 16, v48
  v_and_b32 v25, s41, v48
  v_lshlrev_b32 v26, 16, v49
  v_and_b32 v27, s41, v49
  v_lshlrev_b32 v28, 16, v50
  v_and_b32 v29, s41, v50
  v_lshlrev_b32 v30, 16, v51
  v_and_b32 v31, s41, v51
  v_pk_fma_f32 v[16:17], v[24:25], v[12:13], v[16:17] op_sel:[0,0,0] op_sel_hi:[1,0,1]
  v_pk_fma_f32 v[18:19], v[26:27], v[12:13], v[18:19] op_sel:[0,0,0] op_sel_hi:[1,0,1]
  v_pk_fma_f32 v[20:21], v[28:29], v[12:13], v[20:21] op_sel:[0,0,0] op_sel_hi:[1,0,1]
  v_pk_fma_f32 v[22:23], v[30:31], v[12:13], v[22:23] op_sel:[0,0,0] op_sel_hi:[1,0,1]
  s_cbranch_vccnz L_47
  s_cbranch_scc0 L_48
  s_waitcnt vmcnt(3)
L_48:
  s_waitcnt vmcnt(4)
L_47:
  s_waitcnt vmcnt(5)
  buffer_load_dwordx4 v[48:51], v1, s[24:27], s29 offen offset:0 nt
  v_mov_b32_dpp v13, v10 row_newbcast:10 row_mask:0xf bank_mask:0xf
  v_lshlrev_b32 v24, 16, v52
  v_and_b32 v25, s41, v52
  v_lshlrev_b32 v26, 16, v53
  v_and_b32 v27, s41, v53
  v_lshlrev_b32 v28, 16, v54
  v_and_b32 v29, s41, v54
  v_lshlrev_b32 v30, 16, v55
  v_and_b32 v31, s41, v55
  v_pk_fma_f32 v[16:17], v[24:25], v[12:13], v[16:17] op_sel:[0,1,0] op_sel_hi:[1,1,1]
  v_pk_fma_f32 v[18:19], v[26:27], v[12:13], v[18:19] op_sel:[0,1,0] op_sel_hi:[1,1,1]
  v_pk_fma_f32 v[20:21], v[28:29], v[12:13], v[20:21] op_sel:[0,1,0] op_sel_hi:[1,1,1]
  v_pk_fma_f32 v[22:23], v[30:31], v[12:13], v[22:23] op_sel:[0,1,0] op_sel_hi:[1,1,1]
  s_cbranch_vccnz L_49
  s_cbranch_scc0 L_50
  s_waitcnt vmcnt(3)
L_50:
  s_waitcnt vmcnt(4)
L_49:
  s_waitcnt vmcnt(5)
  buffer_load_dwordx4 v[52:55], v1, s[24:27], s29 offen offset:1024 nt
  v_mov_b32_dpp v12, v10 row_newbcast:6 row_mask:0xf bank_mask:0xf
  v_lshlrev_b32 v24, 16, v56
  v_and_b32 v25, s41, v56
  v_lshlrev_b32 v26, 16, v57
  v_and_b32 v27, s41, v57
  v_lshlrev_b32 v28, 16, v58
  v_and_b32 v29, s41, v58
  v_lshlrev_b32 v30, 16, v59
  v_and_b32 v31, s41, v59
  v_pk_fma_f32 v[16:17], v[24:25], v[12:13], v[16:17] op_sel:[0,0,0] op_sel_hi:[1,0,1]
  v_pk_fma_f32 v[18:19], v[26:27], v[12:13], v[18:19] op_sel:[0,0,0] op_sel_hi:[1,0,1]
  v_pk_fma_f32 v[20:21], v[28:29], v[12:13], v[20:21] op_sel:[0,0,0] op_sel_hi:[1,0,1]
  v_pk_fma_f32 v[22:23], v[30:31], v[12:13], v[22:23] op_sel:[0,0,0] op_sel_hi:[1,0,1]
  s_cbranch_vccnz L_51
  s_cbranch_scc0 L_52
  s_waitcnt vmcnt(3)
L_52:
  s_waitcnt vmcnt(4)
L_51:
  s_waitcnt vmcnt(5)
  buffer_load_dwordx4 v[56:59], v1, s[24:27], s29 offen offset:2048 nt
  v_mov_b32_dpp v13, v10 row_newbcast:14 row_mask:0xf bank_mask:0xf
  v_lshlrev_b32 v24, 16, v60
  v_and_b32 v25, s41, v60
  v_lshlrev_b32 v26, 16, v61
  v_and_b32 v27, s41, v61
  v_lshlrev_b32 v28, 16, v62
  v_and_b32 v29, s41, v62
  v_lshlrev_b32 v30, 16, v63
  v_and_b32 v31, s41, v63
  v_pk_fma_f32 v[16:17], v[24:25], v[12:13], v[16:17] op_sel:[0,1,0] op_sel_hi:[1,1,1]
  v_pk_fma_f32 v[18:19], v[26:27], v[12:13], v[18:19] op_sel:[0,1,0] op_sel_hi:[1,1,1]
  v_pk_fma_f32 v[20:21], v[28:29], v[12:13], v[20:21] op_sel:[0,1,0] op_sel_hi:[1,1,1]
  v_pk_fma_f32 v[22:23], v[30:31], v[12:13], v[22:23] op_sel:[0,1,0] op_sel_hi:[1,1,1]
  s_add_u32 s53, s53, 107
  s_waitcnt lgkmcnt(0)
  s_sub_u32 s70, s53, s74
  s_sub_u32 s3, s70, s54
  s_cmp_gt_i32 s3, -30
  s_cselect_b32 s52, 1, 0
  s_cmp_gt_i32 s3, 30
  s_cselect_b32 s52, 2, s52
  s_cmp_eq_u32 s55, 0
  s_cselect_b32 s52, 1, s52
  s_cmp_ge_u32 s30, 62
  s_cselect_b32 s52, 0, s52
  s_cmp_eq_u32 s52, 0
  s_cselect_b64 vcc, -1, 0
  s_cmp_eq_u32 s52, 2
  s_cbranch_vccnz L_53
  s_cbranch_scc0 L_54
  s_waitcnt vmcnt(3)
L_54:
  s_waitcnt vmcnt(4)
L_53:
  s_waitcnt vmcnt(5)
  buffer_load_dwordx4 v[60:63], v1, s[24:27], s29 offen offset:3072 nt
  s_or_b32 s28, s28, 0x13fff
  s_add_u32 s28, s28, 1
  s_and_b32 s28, s28, 0xec000
  s_or_b32 s29, s28, 0x1000
  s_add_u32 s30, s30, 1
  s_cmp_eq_u32 s30, 32
  s_cselect_b64 s[24:25], s[12:13], s[24:25]
  s_cmp_ge_u32 s30, 64
  s_cselect_b32 s26, 0, s26
  v_mov_b32_dpp v12, v10 row_newbcast:1 row_mask:0xf bank_mask:0xf
  v_lshlrev_b32 v24, 16, v32
  v_and_b32 v25, s41, v32
  v_lshlrev_b32 v26, 16, v33
  v_and_b32 v27, s41, v33
  v_lshlrev_b32 v28, 16, v34
  v_and_b32 v29, s41, v34
  v_lshlrev_b32 v30, 16, v35
  v_and_b32 v31, s41, v35
  v_pk_fma_f32 v[16:17], v[24:25], v[12:13], v[16:17] op_sel:[0,0,0] op_sel_hi:[1,0,1]
  v_pk_fma_f32 v[18:19], v[26:27], v[12:13], v[18:19] op_sel:[0,0,0] op_sel_hi:[1,0,1]
  v_pk_fma_f32 v[20:21], v[28:29], v[12:13], v[20:21] op_sel:[0,0,0] op_sel_hi:[1,0,1]
  v_pk_fma_f32 v[22:23], v[30:31], v[12:13], v[22:23] op_sel:[0,0,0] op_sel_hi:[1,0,1]
  s_cmp_eq_u32 s52, 0
  s_cselect_b64 vcc, -1, 0
  s_cmp_eq_u32 s52, 2
  s_cbranch_vccnz L_55
  s_cbranch_scc0 L_56
  s_waitcnt vmcnt(3)
L_56:
  s_waitcnt vmcnt(4)
L_55:
  s_waitcnt vmcnt(5)
  buffer_load_dwordx4 v[32:35], v1, s[24:27], s28 offen offset:0 nt
  v_mov_b32_dpp v13, v10 row_newbcast:9 row_mask:0xf bank_mask:0xf
  v_lshlrev_b32 v24, 16, v36
  v_and_b32 v25, s41, v36
  v_lshlrev_b32 v26, 16, v37
  v_and_b32 v27, s41, v37
  v_lshlrev_b32 v28, 16, v38
  v_and_b32 v29, s41, v38
  v_lshlrev_b32 v30, 16, v39
  v_and_b32 v31, s41, v39
  v_pk_fma_f32 v[16:17], v[24:25], v[12:13], v[16:17] op_sel:[0,1,0] op_sel_hi:[1,1,1]
  v_pk_fma_f32 v[18:19], v[26:27], v[12:13], v[18:19] op_sel:[0,1,0] op_sel_hi:[1,1,1]
  v_pk_fma_f32 v[20:21], v[28:29], v[12:13], v[20:21] op_sel:[0,1,0] op_sel_hi:[1,1,1]
  v_pk_fma_f32 v[22:23], v[30:31], v[12:13], v[22:23] op_sel:[0,1,0] op_sel_hi:[1,1,1]
  s_cmp_lg_u32 s42, 1
  s_cbranch_scc1 L_57
  s_nop 1
  v_add_f32_dpp v9, v9, v9 row_ror:8 row_mask:0xf bank_mask:0xf
  s_nop 1
  v_add_f32_dpp v9, v9, v9 row_ror:4 row_mask:0xf bank_mask:0xf
  s_nop 1
  v_add_f32_dpp v9, v9, v9 row_ror:2 row_mask:0xf bank_mask:0xf
  s_nop 1
  v_add_f32_dpp v9, v9, v9 row_ror:1 row_mask:0xf bank_mask:0xf
  v_mov_b32 v15, v9
  s_nop 1
  v_permlane16_swap_b32 v9, v15
  s_nop 1
  v_add_f32 v9, v9, v15
  v_mov_b32 v15, v9
  s_nop 1
  v_permlane32_swap_b32 v9, v15
  s_nop 1
  v_add_f32 v9, v9, v15
  s_lshl_b32 s3, s43, 3
  v_mov_b32 v2, s3
  s_mov_b64 exec, 1
  ds_write_b64 v2, v[8:9] offset:18432
  s_mov_b64 exec, -1
  v_mov_b32 v2, 0
  s_waitcnt lgkmcnt(0)
  s_barrier
  ds_read_b128 v[24:27], v2 offset:18432
  ds_read_b128 v[28:31], v2 offset:18448
  s_waitcnt lgkmcnt(0)
  v_max_f32 v15, v24, v26
  v_max3_f32 v15, v15, v28, v30
  v_sub_f32 v8, v8, v15
  v_sub_f32 v24, v24, v15
  v_sub_f32 v26, v26, v15
  v_sub_f32 v28, v28, v15
  v_sub_f32 v30, v30, v15
  v_exp_f32 v8, v8
  v_exp_f32 v24, v24
  v_exp_f32 v26, v26
  v_exp_f32 v28, v28
  v_exp_f32 v30, v30
  s_nop 0
  v_mul_f32 v9, v24, v25
  v_fmac_f32 v9, v26, v27
  v_fmac_f32 v9, v28, v29
  v_fmac_f32 v9, v30, v31
  v_rcp_f32 v9, v9
  s_nop 0
  v_mul_f32 v9, v9, v8
  v_and_b32 v2, 15, v3
  v_lshlrev_b32 v2, 5, v2
  v_lshrrev_b32 v15, 4, v3
  v_lshl_add_u32 v2, v15, 3, v2
  s_lshl_b32 s3, s43, 9
  v_add_u32 v14, s3, v2
  v_lshrrev_b32 v8, 1, v2
L_57:
  s_cmp_eq_u32 s52, 0
  s_cselect_b64 vcc, -1, 0
  s_cmp_eq_u32 s52, 2
  s_cbranch_vccnz L_58
  s_cbranch_scc0 L_59
  s_waitcnt vmcnt(3)
L_59:
  s_waitcnt vmcnt(4)
L_58:
  s_waitcnt vmcnt(5)
  buffer_load_dwordx4 v[36:39], v1, s[24:27], s28 offen offset:1024 nt
  s_memrealtime s[74:75]
  v_mov_b32_dpp v12, v10 row_newbcast:5 row_mask:0xf bank_mask:0xf
  v_lshlrev_b32 v24, 16, v40
  v_and_b32 v25, s41, v40
  v_lshlrev_b32 v26, 16, v41
  v_and_b32 v27, s41, v41
  v_lshlrev_b32 v28, 16, v42
  v_and_b32 v29, s41, v42
  v_lshlrev_b32 v30, 16, v43
  v_and_b32 v31, s41, v43
  v_pk_fma_f32 v[16:17], v[24:25], v[12:13], v[16:17] op_sel:[0,0,0] op_sel_hi:[1,0,1]
  v_pk_fma_f32 v[18:19], v[26:27], v[12:13], v[18:19] op_sel:[0,0,0] op_sel_hi:[1,0,1]
  v_pk_fma_f32 v[20:21], v[28:29], v[12:13], v[20:21] op_sel:[0,0,0] op_sel_hi:[1,0,1]
  v_pk_fma_f32 v[22:23], v[30:31], v[12:13], v[22:23] op_sel:[0,0,0] op_sel_hi:[1,0,1]
  s_cbranch_vccnz L_60
  s_cbranch_scc0 L_61
  s_waitcnt vmcnt(3)
L_61:
  s_waitcnt vmcnt(4)
L_60:
  s_waitcnt vmcnt(5)
  buffer_load_dwordx4 v[40:43], v1, s[24:27], s28 offen offset:2048 nt
  v_mov_b32_dpp v13, v10 row_newbcast:13 row_mask:0xf bank_mask:0xf
  v_lshlrev_b32 v24, 16, v44
  v_and_b32 v25, s41, v44
  v_lshlrev_b32 v26, 16, v45
  v_and_b32 v27, s41, v45
  v_lshlrev_b32 v28, 16, v46
  v_and_b32 v29, s41, v46
  v_lshlrev_b32 v30, 16, v47
  v_and_b32 v31, s41, v47
  v_pk_fma_f32 v[16:17], v[24:25], v[12:13], v[16:17] op_sel:[0,1,0] op_sel_hi:[1,1,1]
  v_pk_fma_f32 v[18:19], v[26:27], v[12:13], v[18:19] op_sel:[0,1,0] op_sel_hi:[1,1,1]
  v_pk_fma_f32 v[20:21], v[28:29], v[12:13], v[20:21] op_sel:[0,1,0] op_sel_hi:[1,1,1]
  v_pk_fma_f32 v[22:23], v[30:31], v[12:13], v[22:23] op_sel:[0,1,0] op_sel_hi:[1,1,1]
  s_cbranch_vccnz L_62
  s_cbranch_scc0 L_63
  s_waitcnt vmcnt(3)
L_63:
  s_waitcnt vmcnt(4)
L_62:
  s_waitcnt vmcnt(5)
  buffer_load_dwordx4 v[44:47], v1, s[24:27], s28 offen offset:3072 nt
  v_mov_b32_dpp v12, v10 row_newbcast:3 row_mask:0xf bank_mask:0xf
  v_lshlrev_b32 v24, 16, v48
  v_and_b32 v25, s41, v48
  v_lshlrev_b32 v26, 16, v49
  v_and_b32 v27, s41, v49
  v_lshlrev_b32 v28, 16, v50
  v_and_b32 v29, s41, v50
  v_lshlrev_b32 v30, 16, v51
  v_and_b32 v31, s41, v51
  v_pk_fma_f32 v[16:17], v[24:25], v[12:13], v[16:17] op_sel:[0,0,0] op_sel_hi:[1,0,1]
  v_pk_fma_f32 v[18:19], v[26:27], v[12:13], v[18:19] op_sel:[0,0,0] op_sel_hi:[1,0,1]
  v_pk_fma_f32 v[20:21], v[28:29], v[12:13], v[20:21] op_sel:[0,0,0] op_sel_hi:[1,0,1]
  v_pk_fma_f32 v[22:23], v[30:31], v[12:13], v[22:23] op_sel:[0,0,0] op_sel_hi:[1,0,1]
  s_lshr_b32 s3, s30, 1
  s_sub_u32 s3, s3, 1
  s_bitcmp1_b32 s72, s3
  s_cbranch_scc0 L_64
  v_subrev_u32 v68, s70, v64
  v_add_u32 v64, 2000, v68
  v_cmp_gt_u32 vcc, 4000, v64
  s_nop 1
  v_cndmask_b32 v68, 0, v68, vcc
  v_mov_b32 v69, v68
  s_nop 1
  v_add_u32_dpp v68, v68, v68 quad_perm:[1,0,3,2] row_mask:0xf bank_mask:0xf
  v_min_i32_dpp v69, v69, v69 quad_perm:[1,0,3,2] row_mask:0xf bank_mask:0xf
  s_nop 0
  v_add_u32_dpp v68, v68, v68 quad_perm:[2,3,0,1] row_mask:0xf bank_mask:0xf
  v_min_i32_dpp v69, v69, v69 quad_perm:[2,3,0,1] row_mask:0xf bank_mask:0xf
  s_nop 0
  v_add_u32_dpp v68, v68, v68 row_half_mirror row_mask:0xf bank_mask:0xf
  v_min_i32_dpp v69, v69, v69 row_half_mirror row_mask:0xf bank_mask:0xf
  s_nop 0
  v_readfirstlane_b32 s3, v68
  v_readfirstlane_b32 s4, v69
  s_cmp_eq_u32 s55, 0
  s_cselect_b32 s5, 2, 5
  s_sub_u32 s6, 8, s5
  s_mul_i32 s3, s3, s6
  s_lshl_b32 s4, s4, 3
  s_mul_i32 s4, s4, s5
  s_add_i32 s3, s3, s4
  s_ashr_i32 s3, s3, 6
  s_add_u32 s3, s70, s3
  s_mul_i32 s4, s79, s69
  s_add_u32 s3, s3, s4
  s_sub_u32 s4, s3, s54
  s_mov_b32 s54, s3
  s_cmp_gt_i32 s4, -20
  s_cselect_b32 s3, 1, 0
  s_add_i32 s3, s3, s79
  s_cmp_lt_i32 s4, -35
  s_cselect_b32 s4, 1, 0
  s_sub_i32 s3, s3, s4
  s_min_i32 s3, s3, 4
  s_cmp_eq_u32 s55, 0
  s_cselect_b32 s79, 0, s3
  s_mov_b32 s55, 1
L_64:
  s_cmp_eq_u32 s52, 0
  s_cselect_b64 vcc, -1, 0
  s_cmp_eq_u32 s52, 2
  s_cbranch_vccnz L_65
  s_cbranch_scc0 L_66
  s_waitcnt vmcnt(3)
L_66:
  s_waitcnt vmcnt(4)
L_65:
  s_waitcnt vmcnt(5)
  buffer_load_dwordx4 v[48:51], v1, s[24:27], s29 offen offset:0 nt
  v_mov_b32_dpp v13, v10 row_newbcast:11 row_mask:0xf bank_mask:0xf
  v_lshlrev_b32 v24, 16, v52
  v_and_b32 v25, s41, v52
  v_lshlrev_b32 v26, 16, v53
  v_and_b32 v27, s41, v53
  v_lshlrev_b32 v28, 16, v54
  v_and_b32 v29, s41, v54
  v_lshlrev_b32 v30, 16, v55
  v_and_b32 v31, s41, v55
  v_pk_fma_f32 v[16:17], v[24:25], v[12:13], v[16:17] op_sel:[0,1,0] op_sel_hi:[1,1,1]
  v_pk_fma_f32 v[18:19], v[26:27], v[12:13], v[18:19] op_sel:[0,1,0] op_sel_hi:[1,1,1]
  v_pk_fma_f32 v[20:21], v[28:29], v[12:13], v[20:21] op_sel:[0,1,0] op_sel_hi:[1,1,1]
  v_pk_fma_f32 v[22:23], v[30:31], v[12:13], v[22:23] op_sel:[0,1,0] op_sel_hi:[1,1,1]
  s_cbranch_vccnz L_67
  s_cbranch_scc0 L_68
  s_waitcnt vmcnt(3)
L_68:
  s_waitcnt vmcnt(4)
L_67:
  s_waitcnt vmcnt(5)
  buffer_load_dwordx4 v[52:55], v1, s[24:27], s29 offen offset:1024 nt
  v_mov_b32_dpp v12, v10 row_newbcast:7 row_mask:0xf bank_mask:0xf
  v_lshlrev_b32 v24, 16, v56
  v_and_b32 v25, s41, v56
  v_lshlrev_b32 v26, 16, v57
  v_and_b32 v27, s41, v57
  v_lshlrev_b32 v28, 16, v58
  v_and_b32 v29, s41, v58
  v_lshlrev_b32 v30, 16, v59
  v_and_b32 v31, s41, v59
  v_pk_fma_f32 v[16:17], v[24:25], v[12:13], v[16:17] op_sel:[0,0,0] op_sel_hi:[1,0,1]
  v_pk_fma_f32 v[18:19], v[26:27], v[12:13], v[18:19] op_sel:[0,0,0] op_sel_hi:[1,0,1]
  v_pk_fma_f32 v[20:21], v[28:29], v[12:13], v[20:21] op_sel:[0,0,0] op_sel_hi:[1,0,1]
  v_pk_fma_f32 v[22:23], v[30:31], v[12:13], v[22:23] op_sel:[0,0,0] op_sel_hi:[1,0,1]
  s_cbranch_vccnz L_69
  s_cbranch_scc0 L_70
  s_waitcnt vmcnt(3)
L_70:
  s_waitcnt vmcnt(4)
L_69:
  s_waitcnt vmcnt(5)
  buffer_load_dwordx4 v[56:59], v1, s[24:27], s29 offen offset:2048 nt
  v_mov_b32_dpp v13, v10 row_newbcast:15 row_mask:0xf bank_mask:0xf
  v_lshlrev_b32 v24, 16, v60
  v_and_b32 v25, s41, v60
  v_lshlrev_b32 v26, 16, v61
  v_and_b32 v27, s41, v61
  v_lshlrev_b32 v28, 16, v62
  v_and_b32 v29, s41, v62
  v_lshlrev_b32 v30, 16, v63
  v_and_b32 v31, s41, v63
  v_pk_fma_f32 v[16:17], v[24:25], v[12:13], v[16:17] op_sel:[0,1,0] op_sel_hi:[1,1,1]
  v_pk_fma_f32 v[18:19], v[26:27], v[12:13], v[18:19] op_sel:[0,1,0] op_sel_hi:[1,1,1]
  v_pk_fma_f32 v[20:21], v[28:29], v[12:13], v[20:21] op_sel:[0,1,0] op_sel_hi:[1,1,1]
  v_pk_fma_f32 v[22:23], v[30:31], v[12:13], v[22:23] op_sel:[0,1,0] op_sel_hi:[1,1,1]
  s_add_u32 s53, s53, 107
  s_waitcnt lgkmcnt(0)
  s_sub_u32 s70, s53, s74
  s_add_u32 s54, s54, s79
  s_sub_u32 s3, s70, s54
  s_cmp_gt_i32 s3, -30
  s_cselect_b32 s52, 1, 0
  s_cmp_gt_i32 s3, 30
  s_cselect_b32 s52, 2, s52
  s_cmp_eq_u32 s55, 0
  s_cselect_b32 s52, 1, s52
  s_cmp_ge_u32 s30, 62
  s_cselect_b32 s52, 0, s52
  s_lshr_b32 s3, s30, 1
  s_bitcmp1_b32 s71, s3
  s_cbranch_scc0 L_71
  v_mov_b32 v68, s70
  buffer_store_dword v68, v66, s[36:39], 0 offen sc1
L_71:
  s_sub_u32 s42, s42, 1
  s_cmp_lg_u32 s42, 0
  s_cbranch_scc1 L_vloop
  v_permlane32_swap_b32 v16, v20
  v_permlane32_swap_b32 v17, v21
  v_permlane32_swap_b32 v18, v22
  v_permlane32_swap_b32 v19, v23
  s_nop 0
  v_add_f32 v16, v16, v20
  v_add_f32 v17, v17, v21
  v_add_f32 v18, v18, v22
  v_add_f32 v19, v19, v23
  s_nop 0
  v_permlane16_swap_b32 v16, v18
  v_permlane16_swap_b32 v17, v19
  s_cmp_eq_u32 s43, 0
  v_add_f32 v16, v16, v18
  v_add_f32 v17, v17, v19
  v_mul_f32 v16, v16, v9
  v_mul_f32 v17, v17, v9
  s_cbranch_scc1 L_w0
  ds_write_b64 v14, v[16:17] offset:16384
  s_waitcnt lgkmcnt(0)
  s_barrier
  s_endpgm
L_w0:
  s_barrier
  ds_read_b64 v[18:19], v2 offset:16896
  ds_read_b64 v[20:21], v2 offset:17408
  ds_read_b64 v[22:23], v2 offset:17920
  s_waitcnt lgkmcnt(1)
  v_pk_add_f32 v[16:17], v[16:17], v[18:19]
  v_pk_add_f32 v[16:17], v[16:17], v[20:21]
  s_waitcnt lgkmcnt(0)
  v_pk_add_f32 v[16:17], v[16:17], v[22:23]
  v_cvt_pk_bf16_f32 v16, v16, v17
  buffer_store_dword v16, v8, s[20:23], 0 offen
L_end:
  s_endpgm
.section .rodata,"a"
.p2align 6
.amdhsa_kernel standalone__softmax_full_bidir__sampling_kernel
  .amdhsa_next_free_vgpr 70
  .amdhsa_next_free_sgpr 80
  .amdhsa_accum_offset 72
  .amdhsa_group_segment_fixed_size 0
  .amdhsa_kernarg_size 48
  .amdhsa_user_sgpr_count 2
  .amdhsa_user_sgpr_kernarg_segment_ptr 1
  .amdhsa_system_sgpr_workgroup_id_x 1
.end_amdhsa_kernel
```
